```python
import torch

def _softmax(x, axis=-1):
    return torch.softmax(x, dim=axis)
def _gelu(x):
    return torch.nn.functional.gelu(x, approximate="tanh")
def _silu(x):
    return torch.nn.functional.silu(x)
def _sigmoid(x):
    return torch.sigmoid(x)
def _layernorm(x, axis=-1, eps=1e-5):
    m = x.mean(dim=axis, keepdim=True)
    v = x.var(dim=axis, keepdim=True, unbiased=False)
    return (x - m) / torch.sqrt(v + eps)
def _scatter_add(tgt, idx, src, axis=0):
    return tgt.clone().index_add_(axis, idx, src)
def _segment_sum(src, seg, n):
    out = torch.zeros((n,) + src.shape[1:], dtype=src.dtype)
    return out.index_add_(0, seg, src)
def _pad(x, pw):
    flat = tuple(v for pair in reversed(pw) for v in pair)
    return torch.nn.functional.pad(x, flat)

kernel_name = 'standalone__paged_block_table_kv_radixattention__decode'

def setup_inputs():

    _w = (lambda a: (lambda t: t.to(torch.bfloat16) if t.is_floating_point() else t)(torch.as_tensor(a)))
    B, H, Hkv, Dh = 1, 32, 4, 128
    Lk = 65536
    bs = 16
    nb = max(2, Lk // bs)
    P = max(1, nb // 2)
    n_phys = P + B * (nb - P)
    shared = torch.arange(P, dtype=torch.int64)
    priv = P + torch.arange(B * (nb - P), dtype=torch.int64).reshape(B, nb - P)
    bt = torch.cat([torch.tile(shared[None, :], (B, 1)), priv], dim=1)
    ctx = nb * bs - (torch.arange(1, B + 1, dtype=torch.int64) * 2654435761) % max(1, (nb * bs - P * bs) // 2)
    return {
        "q": _w((lambda *s: torch.randn(*s, dtype=torch.bfloat16) * 0.8)(B, H, Dh)),
        "k_cache": _w((lambda *s: torch.randn(*s, dtype=torch.bfloat16) * 0.8)(n_phys, bs, Hkv, Dh)),
        "v_cache": _w((lambda *s: torch.randn(*s, dtype=torch.bfloat16) * 0.05)(n_phys, bs, Hkv, Dh)),
        "block_table": _w(bt.to(torch.int64)),
        "ctx_lens": _w(torch.as_tensor(ctx).to(torch.int64)),
    }

def reference(q, k_cache, v_cache, block_table, ctx_lens):
    B, H, Dh = q.shape
    n_phys, bs, Hkv, _ = k_cache.shape
    nb = block_table.shape[1]
    Lk = nb * bs
    rep = H // Hkv
    k = k_cache[block_table].reshape(B, Lk, Hkv, Dh)
    v = v_cache[block_table].reshape(B, Lk, Hkv, Dh)
    k = (lambda x, n, axis: torch.repeat_interleave(x, n, dim=axis))(k, rep, axis=2)
    v = (lambda x, n, axis: torch.repeat_interleave(x, n, dim=axis))(v, rep, axis=2)
    scores = torch.einsum("bhd,bkhd->bhk", q, k) * (Dh ** -0.5)
    pos = torch.arange(Lk)
    valid = pos[None, :] < ctx_lens[:, None]
    scores = torch.where(valid[:, None, :], scores, -1e9)
    p = _softmax(scores, axis=-1)
    return torch.einsum("bhk,bkhd->bhd", p, v)
```

```asm
; @launch grid=(256,1,1) block=(256,1,1) lds=98304
.amdgcn_target "amdgcn-amd-amdhsa--gfx950"
.text
.p2align 8
.globl standalone__paged_block_table_kv_radixattention__decode_kernel
.type standalone__paged_block_table_kv_radixattention__decode_kernel,@function
standalone__paged_block_table_kv_radixattention__decode_kernel:
    s_cmp_ge_u32 s2, 256
    s_cbranch_scc1 L_end1
    s_load_dwordx16 s[4:19], s[0:1], 0
    v_lshrrev_b32 v7, 6, v0
    v_and_b32 v104, 63, v0
    v_readfirstlane_b32 s3, v7
    s_lshl_b32 s44, s2, 5
    s_lshr_b32 s61, s2, 3
    s_or_b32 s44, s44, s61
    s_and_b32 s44, s44, 255
    v_and_b32 v105, 15, v104
    v_lshrrev_b32 v106, 4, v104
    s_lshl_b32 s61, s3, 6
    s_lshr_b32 s45, s44, 2
    s_add_u32 s45, s45, s61
    s_add_u32 s99, s3, s44
    s_and_b32 s99, s99, 3
    s_lshl_b32 s61, s99, 8
    v_lshlrev_b32 v1, 10, v105
    v_lshl_add_u32 v1, v106, 4, v1
    v_add_u32 v1, s61, v1
    v_lshlrev_b32 v2, 12, v106
    v_lshl_add_u32 v2, v105, 4, v2
    v_add_u32 v2, s61, v2
    v_lshlrev_b32 v3, 2, v106
    s_lshl_b32 s62, s99, 11
    v_lshlrev_b32 v102, 8, v105
    v_lshl_add_u32 v102, v106, 4, v102
    v_add_u32 v102, s62, v102
    v_mov_b32 v103, 0x40000000
    v_cmp_gt_u32 vcc, 8, v105
    s_lshl_b32 s64, s44, 2
    v_mov_b32 v107, s45
    v_lshrrev_b32 v107, v106, v107
    v_lshl_add_u32 v107, v105, 8, v107
    v_lshlrev_b32 v107, 2, v107
    v_cndmask_b32 v102, v103, v102, vcc
    s_waitcnt lgkmcnt(0)
    s_add_u32 s48, s10, s64
    s_addc_u32 s49, s11, 0
    s_load_dword s50, s[12:13], 0
    s_load_dword s36, s[48:49], 0
    s_load_dword s37, s[48:49], 1024
    s_load_dword s38, s[48:49], 2048
    s_load_dword s39, s[48:49], 3072
    s_mov_b32 s40, s10
    s_and_b32 s41, s11, 0xffff
    s_mov_b32 s42, 0x4000
    s_mov_b32 s43, 0x00020000
    buffer_load_dword v110, v107, s[40:43], 0 offen
    s_mov_b32 s28, s4
    s_and_b32 s29, s5, 0xffff
    s_mov_b32 s30, 0x2000
    s_mov_b32 s31, 0x00020000
    s_mov_b32 s20, s6
    s_and_b32 s21, s7, 0xffff
    s_mov_b32 s22, 0x4000000
    s_mov_b32 s23, 0x00020000
    s_mov_b32 s24, s8
    s_and_b32 s25, s9, 0xffff
    s_mov_b32 s26, 0x4000000
    s_mov_b32 s27, 0x00020000
    s_mov_b32 s32, s18
    s_and_b32 s33, s19, 0xffff
    s_mov_b32 s34, 0x701040
    s_mov_b32 s35, 0x00020000
    s_mov_b32 s72, s16
    s_and_b32 s73, s17, 0xffff
    s_mov_b32 s74, 0x100
    s_mov_b32 s75, 0x00020000
    s_mov_b32 s76, s14
    s_and_b32 s77, s15, 0xffff
    s_mov_b32 s78, 0x2000
    s_mov_b32 s79, 0x00020000
    buffer_load_dwordx4 v[8:11], v102, s[28:31], 0 offen offset:0
    buffer_load_dwordx4 v[12:15], v102, s[28:31], 0 offen offset:64
    buffer_load_dwordx4 v[16:19], v102, s[28:31], 0 offen offset:128
    buffer_load_dwordx4 v[20:23], v102, s[28:31], 0 offen offset:192
    s_mov_b32 s52, 0x05040100
    s_mov_b32 s53, 0x07060302
    v_mov_b32 v4, 0xf149f2ca
    v_mov_b32 v5, 0
    v_mov_b32 v109, 0
    v_mov_b32 v253, 0
    v_mov_b32 v255, -1
    v_mov_b32 v24, 0
    v_mov_b32 v25, 0
    v_mov_b32 v26, 0
    v_mov_b32 v27, 0
    v_mov_b32 v28, 0
    v_mov_b32 v29, 0
    v_mov_b32 v30, 0
    v_mov_b32 v31, 0
    v_mov_b32 v32, 0
    v_mov_b32 v33, 0
    v_mov_b32 v34, 0
    v_mov_b32 v35, 0
    v_mov_b32 v36, 0
    v_mov_b32 v37, 0
    v_mov_b32 v38, 0
    v_mov_b32 v39, 0
    v_mov_b32 v40, 0
    v_mov_b32 v41, 0
    v_mov_b32 v42, 0
    v_mov_b32 v43, 0
    v_mov_b32 v44, 0
    v_mov_b32 v45, 0
    v_mov_b32 v46, 0
    v_mov_b32 v47, 0
    v_mov_b32 v48, 0
    v_mov_b32 v49, 0
    v_mov_b32 v50, 0
    v_mov_b32 v51, 0
    v_mov_b32 v52, 0
    v_mov_b32 v53, 0
    v_mov_b32 v54, 0
    v_mov_b32 v55, 0
    s_waitcnt lgkmcnt(0)
    s_cmp_lt_i32 s50, 1
    s_cselect_b32 s51, 0, 0x3e0293ee
    s_cselect_b32 s50, 0x10000, s50
    s_min_i32 s50, s50, 0x10000
    s_lshr_b32 s47, s50, 13
    s_and_b32 s64, s50, 8191
    s_add_u32 s65, s64, 15
    s_lshr_b32 s65, s65, 4
    s_cmp_gt_u32 s65, 256
    s_cselect_b32 s66, 256, 0
    s_cselect_b32 s97, 1, 0
    s_sub_u32 s65, s65, s66
    s_mov_b32 s67, 0
    s_cmp_le_u32 s65, 128
    s_cselect_b32 s67, 1, s67
    s_cmp_le_u32 s65, 64
    s_cselect_b32 s67, 2, s67
    s_lshl_b32 s46, s47, 1
    s_lshl_b32 s96, s67, 4
    s_add_u32 s96, s96, s46
    s_add_u32 s96, s96, s97
    s_lshr_b32 s61, s45, s67
    s_add_u32 s66, s66, s61
    s_sub_u32 s61, 4, s67
    s_lshl_b32 s62, s45, s61
    s_and_b32 s62, s62, 15
    s_lshr_b32 s63, 16, s67
    s_lshl_b32 s61, s66, 4
    s_sub_i32 s98, s64, s61
    s_sub_i32 s98, s98, s62
    s_max_i32 s98, s98, 0
    s_min_i32 s98, s98, s63
    s_cmp_gt_i32 s98, 0
    s_cselect_b32 s61, 2, 0
    s_or_b32 s97, s97, s61
    s_cbranch_scc0 L_norem
    v_mov_b32 v103, 0x40000000
    v_subrev_u32 v7, s62, v105
    v_cmp_gt_u32 vcc, s63, v7
    v_subrev_u32 v250, s62, v3
    s_waitcnt vmcnt(4)
    v_cndmask_b32 v111, v103, v1, vcc
    v_cmp_gt_u32 vcc, s63, v250
    v_readlane_b32 s58, v110, s46
    v_readlane_b32 s59, v110, s96
    v_cndmask_b32 v249, v103, v2, vcc
    s_lshl_b32 s58, s58, 14
    s_lshl_b32 s59, s59, 14
    s_bitcmp1_b32 s97, 1
    s_cselect_b32 s59, s59, 0x80000000
    s_bitcmp1_b32 s97, 0
    s_cbranch_scc0 L_rk_noa
    buffer_load_dwordx4 v[68:71], v1, s[20:23], s58 offen offset:0 nt
    buffer_load_dwordx4 v[72:75], v1, s[20:23], s58 offen offset:64 nt
    buffer_load_dwordx4 v[76:79], v1, s[20:23], s58 offen offset:128 nt
    buffer_load_dwordx4 v[80:83], v1, s[20:23], s58 offen offset:192 nt
L_rk_noa:
    buffer_load_dwordx4 v[84:87], v111, s[20:23], s59 offen offset:0 nt
    buffer_load_dwordx4 v[88:91], v111, s[20:23], s59 offen offset:64 nt
    buffer_load_dwordx4 v[92:95], v111, s[20:23], s59 offen offset:128 nt
    buffer_load_dwordx4 v[96:99], v111, s[20:23], s59 offen offset:192 nt
    s_cbranch_scc0 L_rv_noa
    buffer_load_dwordx4 v[24:27], v2, s[24:27], s58 offen offset:0 nt
    buffer_load_dwordx4 v[28:31], v2, s[24:27], s58 offen offset:1024 nt
    buffer_load_dwordx4 v[32:35], v2, s[24:27], s58 offen offset:2048 nt
    buffer_load_dwordx4 v[36:39], v2, s[24:27], s58 offen offset:3072 nt
L_rv_noa:
    buffer_load_dwordx4 v[40:43], v249, s[24:27], s59 offen offset:0 nt
    buffer_load_dwordx4 v[44:47], v249, s[24:27], s59 offen offset:1024 nt
    buffer_load_dwordx4 v[48:51], v249, s[24:27], s59 offen offset:2048 nt
    buffer_load_dwordx4 v[52:55], v249, s[24:27], s59 offen offset:3072 nt
L_norem:
    s_cmp_gt_u32 s47, 0
    s_cselect_b32 s54, 3, 0
    s_lshl_b32 s58, s36, 14
    s_lshl_b32 s59, s37, 14
    s_cmp_gt_i32 s54, 0
    s_cselect_b32 s58, s58, 0x80000000
    s_cselect_b32 s59, s59, 0x80000000
    buffer_load_dwordx4 v[112:115], v1, s[20:23], s58 offen offset:0 nt
    buffer_load_dwordx4 v[116:119], v1, s[20:23], s58 offen offset:64 nt
    buffer_load_dwordx4 v[120:123], v1, s[20:23], s58 offen offset:128 nt
    buffer_load_dwordx4 v[124:127], v1, s[20:23], s58 offen offset:192 nt
    buffer_load_dwordx4 v[128:131], v1, s[20:23], s59 offen offset:0 nt
    buffer_load_dwordx4 v[132:135], v1, s[20:23], s59 offen offset:64 nt
    buffer_load_dwordx4 v[136:139], v1, s[20:23], s59 offen offset:128 nt
    buffer_load_dwordx4 v[140:143], v1, s[20:23], s59 offen offset:192 nt
    buffer_load_dwordx4 v[144:147], v2, s[24:27], s58 offen offset:0 nt
    buffer_load_dwordx4 v[148:151], v2, s[24:27], s58 offen offset:1024 nt
    buffer_load_dwordx4 v[152:155], v2, s[24:27], s58 offen offset:2048 nt
    buffer_load_dwordx4 v[156:159], v2, s[24:27], s58 offen offset:3072 nt
    buffer_load_dwordx4 v[160:163], v2, s[24:27], s59 offen offset:0 nt
    buffer_load_dwordx4 v[164:167], v2, s[24:27], s59 offen offset:1024 nt
    buffer_load_dwordx4 v[168:171], v2, s[24:27], s59 offen offset:2048 nt
    buffer_load_dwordx4 v[172:175], v2, s[24:27], s59 offen offset:3072 nt
    s_cmp_gt_u32 s47, 1
    s_cselect_b32 s55, 3, 0
    s_lshl_b32 s58, s38, 14
    s_lshl_b32 s59, s39, 14
    s_cmp_gt_i32 s55, 0
    s_cselect_b32 s58, s58, 0x80000000
    s_cselect_b32 s59, s59, 0x80000000
    buffer_load_dwordx4 v[176:179], v1, s[20:23], s58 offen offset:0 nt
    buffer_load_dwordx4 v[180:183], v1, s[20:23], s58 offen offset:64 nt
    buffer_load_dwordx4 v[184:187], v1, s[20:23], s58 offen offset:128 nt
    buffer_load_dwordx4 v[188:191], v1, s[20:23], s58 offen offset:192 nt
    buffer_load_dwordx4 v[192:195], v1, s[20:23], s59 offen offset:0 nt
    buffer_load_dwordx4 v[196:199], v1, s[20:23], s59 offen offset:64 nt
    buffer_load_dwordx4 v[200:203], v1, s[20:23], s59 offen offset:128 nt
    buffer_load_dwordx4 v[204:207], v1, s[20:23], s59 offen offset:192 nt
    buffer_load_dwordx4 v[208:211], v2, s[24:27], s58 offen offset:0 nt
    buffer_load_dwordx4 v[212:215], v2, s[24:27], s58 offen offset:1024 nt
    buffer_load_dwordx4 v[216:219], v2, s[24:27], s58 offen offset:2048 nt
    buffer_load_dwordx4 v[220:223], v2, s[24:27], s58 offen offset:3072 nt
    buffer_load_dwordx4 v[224:227], v2, s[24:27], s59 offen offset:0 nt
    buffer_load_dwordx4 v[228:231], v2, s[24:27], s59 offen offset:1024 nt
    buffer_load_dwordx4 v[232:235], v2, s[24:27], s59 offen offset:2048 nt
    buffer_load_dwordx4 v[236:239], v2, s[24:27], s59 offen offset:3072 nt
    s_or_b32 s61, s44, s3
    s_cmp_lg_u32 s61, 0
    s_cbranch_scc1 L_notagmk
    s_add_u32 s40, s18, 0x701000
    s_addc_u32 s41, s19, 0
    s_load_dword s64, s[40:41], 0
    s_memrealtime s[66:67]
    s_waitcnt lgkmcnt(0)
    s_mul_i32 s65, s66, 0x9e3779b1
    s_lshr_b32 s66, s65, 16
    s_xor_b32 s65, s65, s66
    s_xor_b32 s64, s64, s65
    s_and_b32 s66, s64, 0xff
    s_cselect_b32 s66, 0, 0x1
    s_xor_b32 s65, s65, s66
    s_and_b32 s66, s64, 0xff00
    s_cselect_b32 s66, 0, 0x100
    s_xor_b32 s65, s65, s66
    s_and_b32 s66, s64, 0xff0000
    s_cselect_b32 s66, 0, 0x10000
    s_xor_b32 s65, s65, s66
    s_and_b32 s66, s64, 0xff000000
    s_cselect_b32 s66, 0, 0x1000000
    s_xor_b32 s65, s65, s66
    v_mov_b32 v7, s65
    v_mov_b32 v6, s65
    v_mov_b32 v7, 1
    s_mov_b64 exec, 1
    s_mov_b32 s66, 0x701000
    buffer_store_dwordx2 v[6:7], off, s[72:75], 0 sc1
    buffer_store_dword v6, off, s[32:35], s66 sc1
    s_mov_b64 exec, -1
L_notagmk:
    s_mul_i32 s61, s3, 2176
    v_mul_u32_u24 v240, 272, v105
    v_lshl_add_u32 v240, v106, 6, v240
    v_add_u32 v240, s61, v240
    v_mul_u32_u24 v241, 272, v106
    v_lshl_add_u32 v241, v105, 4, v241
    v_add_u32 v241, s61, v241
    v_lshlrev_b32 v242, 4, v104
    v_and_b32 v6, 1, v104
    v_lshrrev_b32 v7, 1, v104
    v_lshl_add_u32 v102, v6, 5, v7
    v_lshlrev_b32 v243, 3, v6
    s_mov_b32 s61, 8704
    v_mul_lo_u32 v244, v102, s61
    v_mul_lo_u32 v245, v7, s61
    v_lshl_add_u32 v245, v6, 4, v245
    v_lshlrev_b32 v246, 4, v6
    v_lshl_add_u32 v248, v106, 2, v246
    v_lshl_add_u32 v246, v106, 5, v246
    s_lshl_b32 s61, s3, 7
    s_add_u32 s61, s61, 20480
    v_add_u32 v247, s61, v246
    s_mul_i32 s5, s44, 8704
    s_lshl_b32 s61, s99, 11
    s_add_u32 s4, s5, s61
    s_lshl_b32 s61, s99, 7
    s_add_u32 s5, s5, s61
    s_add_u32 s5, s5, 8192
    s_mul_i32 s14, s3, 557056
    s_lshl_b32 s15, s44, 5
    s_add_u32 s8, s14, s15
    s_add_u32 s9, s8, 278528
    s_lshr_b32 s61, s44, 3
    s_lshl_b32 s62, s61, 4
    s_add_u32 s14, s14, s62
    s_add_u32 s14, s14, 8192
    s_mov_b32 s64, 0x4b002000
    s_mov_b32 s65, 0x4b002000
    s_mov_b32 s66, 0x17800000
    s_mov_b32 s67, 0x34000000
    s_mov_b32 s6, 0x00030003
    s_mov_b32 s7, 0x00030003
    s_mov_b32 s12, 0xc000c000
    s_mov_b32 s68, 0x00ff00ff
    s_mov_b32 s69, 0x00ff00ff
    s_mov_b32 s60, 2
    s_lshl_b32 s63, s60, 11
    s_cmp_lt_u32 s60, s47
    s_cselect_b32 s63, s63, 0
    s_cselect_b32 s56, 3, 0
    s_add_u32 s61, s63, 1024
    s_load_dword s36, s[48:49], s63
    s_load_dword s37, s[48:49], s61
    s_add_u32 s60, s60, 1
    s_cmp_eq_u32 s97, 0
    s_cbranch_scc1 L_remdone
L_tile3_0:
    s_waitcnt vmcnt(36)
    v_mfma_f32_16x16x32_bf16 v[56:59], v[68:71], v[8:11], 0
    v_mfma_f32_16x16x32_bf16 v[60:63], v[84:87], v[8:11], 0
    v_mfma_f32_16x16x32_bf16 v[56:59], v[72:75], v[12:15], v[56:59]
    v_mfma_f32_16x16x32_bf16 v[60:63], v[88:91], v[12:15], v[60:63]
    v_mfma_f32_16x16x32_bf16 v[56:59], v[76:79], v[16:19], v[56:59]
    v_mfma_f32_16x16x32_bf16 v[60:63], v[92:95], v[16:19], v[60:63]
    v_mfma_f32_16x16x32_bf16 v[56:59], v[80:83], v[20:23], v[56:59]
    v_mfma_f32_16x16x32_bf16 v[60:63], v[96:99], v[20:23], v[60:63]
    s_waitcnt vmcnt(32)
    v_perm_b32 v68, v28, v24, s52
    v_perm_b32 v72, v28, v24, s53
    v_perm_b32 v69, v36, v32, s52
    v_perm_b32 v73, v36, v32, s53
    v_perm_b32 v70, v44, v40, s52
    v_perm_b32 v74, v44, v40, s53
    v_perm_b32 v71, v52, v48, s52
    v_perm_b32 v75, v52, v48, s53
    v_perm_b32 v76, v29, v25, s52
    v_perm_b32 v80, v29, v25, s53
    v_perm_b32 v77, v37, v33, s52
    v_perm_b32 v81, v37, v33, s53
    v_perm_b32 v78, v45, v41, s52
    v_perm_b32 v82, v45, v41, s53
    v_perm_b32 v79, v53, v49, s52
    v_perm_b32 v83, v53, v49, s53
    v_perm_b32 v84, v30, v26, s52
    v_perm_b32 v88, v30, v26, s53
    v_perm_b32 v85, v38, v34, s52
    v_perm_b32 v89, v38, v34, s53
    v_perm_b32 v86, v46, v42, s52
    v_perm_b32 v90, v46, v42, s53
    v_perm_b32 v87, v54, v50, s52
    v_perm_b32 v91, v54, v50, s53
    v_perm_b32 v92, v31, v27, s52
    v_perm_b32 v96, v31, v27, s53
    v_perm_b32 v93, v39, v35, s52
    v_perm_b32 v97, v39, v35, s53
    v_perm_b32 v94, v47, v43, s52
    v_perm_b32 v98, v47, v43, s53
    v_perm_b32 v95, v55, v51, s52
    v_perm_b32 v99, v55, v51, s53
    v_mov_b32 v102, 0xff800000
    s_bitcmp1_b32 s97, 0
    s_cbranch_scc1 L_hasa3_0
    v_mov_b32 v56, v102
    v_mov_b32 v57, v102
    v_mov_b32 v58, v102
    v_mov_b32 v59, v102
L_hasa3_0:
    v_add_u32 v7, 0, v250
    v_cmp_gt_u32 vcc, s98, v7
    s_nop 1
    v_cndmask_b32 v60, v102, v60, vcc
    v_add_u32 v7, 1, v250
    v_cmp_gt_u32 vcc, s98, v7
    s_nop 1
    v_cndmask_b32 v61, v102, v61, vcc
    v_add_u32 v7, 2, v250
    v_cmp_gt_u32 vcc, s98, v7
    s_nop 1
    v_cndmask_b32 v62, v102, v62, vcc
    v_add_u32 v7, 3, v250
    v_cmp_gt_u32 vcc, s98, v7
    s_nop 1
    v_cndmask_b32 v63, v102, v63, vcc
L_nomask3_0:
    v_max3_f32 v6, v56, v57, v58
    v_max3_f32 v6, v6, v59, v60
    v_max3_f32 v6, v6, v61, v62
    v_max_f32 v6, v6, v63
    v_mov_b32 v7, v6
    s_nop 1
    v_permlane16_swap_b32 v6, v7
    v_max_f32 v6, v6, v7
    v_mov_b32 v7, v6
    s_nop 1
    v_permlane32_swap_b32 v6, v7
    v_max_f32 v6, v6, v7
    v_mul_f32 v6, s51, v6
    v_max_f32 v101, v4, v6
    v_sub_f32 v100, v4, v101
    v_exp_f32 v100, v100
    v_mov_b32 v4, v101
    v_fma_f32 v56, v56, s51, -v101
    v_fma_f32 v57, v57, s51, -v101
    v_fma_f32 v58, v58, s51, -v101
    v_fma_f32 v59, v59, s51, -v101
    v_fma_f32 v60, v60, s51, -v101
    v_fma_f32 v61, v61, s51, -v101
    v_fma_f32 v62, v62, s51, -v101
    v_fma_f32 v63, v63, s51, -v101
    v_exp_f32 v56, v56
    v_exp_f32 v57, v57
    v_exp_f32 v58, v58
    v_exp_f32 v59, v59
    v_exp_f32 v60, v60
    v_exp_f32 v61, v61
    v_exp_f32 v62, v62
    v_exp_f32 v63, v63
    v_mul_f32 v5, v100, v5
    v_add_f32 v7, v56, v57
    v_add_f32 v102, v58, v59
    v_add_f32 v103, v60, v61
    v_add_f32 v6, v62, v63
    v_cvt_pk_bf16_f32 v64, v56, v57
    v_cvt_pk_bf16_f32 v65, v58, v59
    v_cvt_pk_bf16_f32 v66, v60, v61
    v_cvt_pk_bf16_f32 v67, v62, v63
    v_add_f32 v7, v7, v102
    v_add_f32 v103, v103, v6
    v_add_f32 v7, v7, v103
    v_add_f32 v5, v5, v7
    v_mfma_f32_16x16x32_bf16 v[24:27], v[68:71], v[64:67], 0
    v_mfma_f32_16x16x32_bf16 v[28:31], v[72:75], v[64:67], 0
    v_mfma_f32_16x16x32_bf16 v[32:35], v[76:79], v[64:67], 0
    v_mfma_f32_16x16x32_bf16 v[36:39], v[80:83], v[64:67], 0
    v_mfma_f32_16x16x32_bf16 v[40:43], v[84:87], v[64:67], 0
    v_mfma_f32_16x16x32_bf16 v[44:47], v[88:91], v[64:67], 0
    v_mfma_f32_16x16x32_bf16 v[48:51], v[92:95], v[64:67], 0
    v_mfma_f32_16x16x32_bf16 v[52:55], v[96:99], v[64:67], 0
L_remdone:
    s_cmp_lt_i32 s54, 1
    s_cbranch_scc1 L_epi
L_tile0_0:
    s_cmp_lt_i32 s56, 1
    s_cbranch_scc1 L_tile1_0
    s_waitcnt vmcnt(24)
    v_mfma_f32_16x16x32_bf16 v[56:59], v[112:115], v[8:11], 0
    v_mfma_f32_16x16x32_bf16 v[60:63], v[128:131], v[8:11], 0
    v_mfma_f32_16x16x32_bf16 v[56:59], v[116:119], v[12:15], v[56:59]
    v_mfma_f32_16x16x32_bf16 v[60:63], v[132:135], v[12:15], v[60:63]
    v_mfma_f32_16x16x32_bf16 v[56:59], v[120:123], v[16:19], v[56:59]
    v_mfma_f32_16x16x32_bf16 v[60:63], v[136:139], v[16:19], v[60:63]
    v_mfma_f32_16x16x32_bf16 v[56:59], v[124:127], v[20:23], v[56:59]
    v_mfma_f32_16x16x32_bf16 v[60:63], v[140:143], v[20:23], v[60:63]
    s_waitcnt lgkmcnt(0)
    s_lshl_b32 s58, s36, 14
    s_lshl_b32 s59, s37, 14
    buffer_load_dwordx4 v[112:115], v1, s[20:23], s58 offen offset:0 nt
    buffer_load_dwordx4 v[116:119], v1, s[20:23], s58 offen offset:64 nt
    buffer_load_dwordx4 v[120:123], v1, s[20:23], s58 offen offset:128 nt
    buffer_load_dwordx4 v[124:127], v1, s[20:23], s58 offen offset:192 nt
    buffer_load_dwordx4 v[128:131], v1, s[20:23], s59 offen offset:0 nt
    buffer_load_dwordx4 v[132:135], v1, s[20:23], s59 offen offset:64 nt
    buffer_load_dwordx4 v[136:139], v1, s[20:23], s59 offen offset:128 nt
    buffer_load_dwordx4 v[140:143], v1, s[20:23], s59 offen offset:192 nt
    s_waitcnt vmcnt(24)
    v_perm_b32 v68, v148, v144, s52
    v_perm_b32 v72, v148, v144, s53
    v_perm_b32 v69, v156, v152, s52
    v_perm_b32 v73, v156, v152, s53
    v_perm_b32 v70, v164, v160, s52
    v_perm_b32 v74, v164, v160, s53
    v_perm_b32 v71, v172, v168, s52
    v_perm_b32 v75, v172, v168, s53
    v_perm_b32 v76, v149, v145, s52
    v_perm_b32 v80, v149, v145, s53
    v_perm_b32 v77, v157, v153, s52
    v_perm_b32 v81, v157, v153, s53
    v_perm_b32 v78, v165, v161, s52
    v_perm_b32 v82, v165, v161, s53
    v_perm_b32 v79, v173, v169, s52
    v_perm_b32 v83, v173, v169, s53
    v_perm_b32 v84, v150, v146, s52
    v_perm_b32 v88, v150, v146, s53
    v_perm_b32 v85, v158, v154, s52
    v_perm_b32 v89, v158, v154, s53
    v_perm_b32 v86, v166, v162, s52
    v_perm_b32 v90, v166, v162, s53
    v_perm_b32 v87, v174, v170, s52
    v_perm_b32 v91, v174, v170, s53
    v_perm_b32 v92, v151, v147, s52
    v_perm_b32 v96, v151, v147, s53
    v_perm_b32 v93, v159, v155, s52
    v_perm_b32 v97, v159, v155, s53
    v_perm_b32 v94, v167, v163, s52
    v_perm_b32 v98, v167, v163, s53
    v_perm_b32 v95, v175, v171, s52
    v_perm_b32 v99, v175, v171, s53
    buffer_load_dwordx4 v[144:147], v2, s[24:27], s58 offen offset:0 nt
    buffer_load_dwordx4 v[148:151], v2, s[24:27], s58 offen offset:1024 nt
    buffer_load_dwordx4 v[152:155], v2, s[24:27], s58 offen offset:2048 nt
    buffer_load_dwordx4 v[156:159], v2, s[24:27], s58 offen offset:3072 nt
    buffer_load_dwordx4 v[160:163], v2, s[24:27], s59 offen offset:0 nt
    buffer_load_dwordx4 v[164:167], v2, s[24:27], s59 offen offset:1024 nt
    buffer_load_dwordx4 v[168:171], v2, s[24:27], s59 offen offset:2048 nt
    buffer_load_dwordx4 v[172:175], v2, s[24:27], s59 offen offset:3072 nt
    s_cmp_lg_u32 s60, 4
    s_cbranch_scc1 L_notag0
    buffer_load_dwordx2 v[108:109], off, s[72:75], 0 sc1
L_notag0:
    s_lshl_b32 s63, s60, 11
    s_cmp_lt_u32 s60, s47
    s_cselect_b32 s63, s63, 0
    s_cselect_b32 s57, 3, 0
    s_add_u32 s61, s63, 1024
    s_load_dword s38, s[48:49], s63
    s_load_dword s39, s[48:49], s61
    s_add_u32 s60, s60, 1
L_nomask0_0:
    v_max3_f32 v6, v56, v57, v58
    v_max3_f32 v6, v6, v59, v60
    v_max3_f32 v6, v6, v61, v62
    v_max_f32 v6, v6, v63
    v_mov_b32 v7, v6
    s_nop 1
    v_permlane16_swap_b32 v6, v7
    v_max_f32 v6, v6, v7
    v_mov_b32 v7, v6
    s_nop 1
    v_permlane32_swap_b32 v6, v7
    v_max_f32 v6, v6, v7
    v_mul_f32 v6, s51, v6
    v_max_f32 v101, v4, v6
    v_sub_f32 v100, v4, v101
    v_exp_f32 v100, v100
    v_mov_b32 v4, v101
    v_fma_f32 v56, v56, s51, -v101
    v_fma_f32 v57, v57, s51, -v101
    v_fma_f32 v58, v58, s51, -v101
    v_fma_f32 v59, v59, s51, -v101
    v_fma_f32 v60, v60, s51, -v101
    v_fma_f32 v61, v61, s51, -v101
    v_fma_f32 v62, v62, s51, -v101
    v_fma_f32 v63, v63, s51, -v101
    v_exp_f32 v56, v56
    v_exp_f32 v57, v57
    v_exp_f32 v58, v58
    v_exp_f32 v59, v59
    v_exp_f32 v60, v60
    v_exp_f32 v61, v61
    v_exp_f32 v62, v62
    v_exp_f32 v63, v63
    v_mul_f32 v24, v100, v24
    v_mul_f32 v25, v100, v25
    v_mul_f32 v26, v100, v26
    v_mul_f32 v27, v100, v27
    v_mul_f32 v28, v100, v28
    v_mul_f32 v29, v100, v29
    v_mul_f32 v30, v100, v30
    v_mul_f32 v31, v100, v31
    v_mul_f32 v32, v100, v32
    v_mul_f32 v33, v100, v33
    v_mul_f32 v34, v100, v34
    v_mul_f32 v35, v100, v35
    v_mul_f32 v36, v100, v36
    v_mul_f32 v37, v100, v37
    v_mul_f32 v38, v100, v38
    v_mul_f32 v39, v100, v39
    v_mul_f32 v40, v100, v40
    v_mul_f32 v41, v100, v41
    v_mul_f32 v42, v100, v42
    v_mul_f32 v43, v100, v43
    v_mul_f32 v44, v100, v44
    v_mul_f32 v45, v100, v45
    v_mul_f32 v46, v100, v46
    v_mul_f32 v47, v100, v47
    v_mul_f32 v48, v100, v48
    v_mul_f32 v49, v100, v49
    v_mul_f32 v50, v100, v50
    v_mul_f32 v51, v100, v51
    v_mul_f32 v52, v100, v52
    v_mul_f32 v53, v100, v53
    v_mul_f32 v54, v100, v54
    v_mul_f32 v55, v100, v55
    v_mul_f32 v5, v100, v5
    v_add_f32 v7, v56, v57
    v_add_f32 v102, v58, v59
    v_add_f32 v103, v60, v61
    v_add_f32 v6, v62, v63
    v_cvt_pk_bf16_f32 v64, v56, v57
    v_cvt_pk_bf16_f32 v65, v58, v59
    v_cvt_pk_bf16_f32 v66, v60, v61
    v_cvt_pk_bf16_f32 v67, v62, v63
    v_add_f32 v7, v7, v102
    v_add_f32 v103, v103, v6
    v_add_f32 v7, v7, v103
    v_add_f32 v5, v5, v7
    v_mfma_f32_16x16x32_bf16 v[24:27], v[68:71], v[64:67], v[24:27]
    v_mfma_f32_16x16x32_bf16 v[28:31], v[72:75], v[64:67], v[28:31]
    v_mfma_f32_16x16x32_bf16 v[32:35], v[76:79], v[64:67], v[32:35]
    v_mfma_f32_16x16x32_bf16 v[36:39], v[80:83], v[64:67], v[36:39]
    v_mfma_f32_16x16x32_bf16 v[40:43], v[84:87], v[64:67], v[40:43]
    v_mfma_f32_16x16x32_bf16 v[44:47], v[88:91], v[64:67], v[44:47]
    v_mfma_f32_16x16x32_bf16 v[48:51], v[92:95], v[64:67], v[48:51]
    v_mfma_f32_16x16x32_bf16 v[52:55], v[96:99], v[64:67], v[52:55]
    s_mov_b32 s54, s56
L_tile0_1:
    s_cmp_lt_i32 s57, 1
    s_cbranch_scc1 L_tile1_1
    s_waitcnt vmcnt(24)
    v_mfma_f32_16x16x32_bf16 v[56:59], v[176:179], v[8:11], 0
    v_mfma_f32_16x16x32_bf16 v[60:63], v[192:195], v[8:11], 0
    v_mfma_f32_16x16x32_bf16 v[56:59], v[180:183], v[12:15], v[56:59]
    v_mfma_f32_16x16x32_bf16 v[60:63], v[196:199], v[12:15], v[60:63]
    v_mfma_f32_16x16x32_bf16 v[56:59], v[184:187], v[16:19], v[56:59]
    v_mfma_f32_16x16x32_bf16 v[60:63], v[200:203], v[16:19], v[60:63]
    v_mfma_f32_16x16x32_bf16 v[56:59], v[188:191], v[20:23], v[56:59]
    v_mfma_f32_16x16x32_bf16 v[60:63], v[204:207], v[20:23], v[60:63]
    s_waitcnt lgkmcnt(0)
    s_lshl_b32 s58, s38, 14
    s_lshl_b32 s59, s39, 14
    buffer_load_dwordx4 v[176:179], v1, s[20:23], s58 offen offset:0 nt
    buffer_load_dwordx4 v[180:183], v1, s[20:23], s58 offen offset:64 nt
    buffer_load_dwordx4 v[184:187], v1, s[20:23], s58 offen offset:128 nt
    buffer_load_dwordx4 v[188:191], v1, s[20:23], s58 offen offset:192 nt
    buffer_load_dwordx4 v[192:195], v1, s[20:23], s59 offen offset:0 nt
    buffer_load_dwordx4 v[196:199], v1, s[20:23], s59 offen offset:64 nt
    buffer_load_dwordx4 v[200:203], v1, s[20:23], s59 offen offset:128 nt
    buffer_load_dwordx4 v[204:207], v1, s[20:23], s59 offen offset:192 nt
    s_waitcnt vmcnt(24)
    v_perm_b32 v68, v212, v208, s52
    v_perm_b32 v72, v212, v208, s53
    v_perm_b32 v69, v220, v216, s52
    v_perm_b32 v73, v220, v216, s53
    v_perm_b32 v70, v228, v224, s52
    v_perm_b32 v74, v228, v224, s53
    v_perm_b32 v71, v236, v232, s52
    v_perm_b32 v75, v236, v232, s53
    v_perm_b32 v76, v213, v209, s52
    v_perm_b32 v80, v213, v209, s53
    v_perm_b32 v77, v221, v217, s52
    v_perm_b32 v81, v221, v217, s53
    v_perm_b32 v78, v229, v225, s52
    v_perm_b32 v82, v229, v225, s53
    v_perm_b32 v79, v237, v233, s52
    v_perm_b32 v83, v237, v233, s53
    v_perm_b32 v84, v214, v210, s52
    v_perm_b32 v88, v214, v210, s53
    v_perm_b32 v85, v222, v218, s52
    v_perm_b32 v89, v222, v218, s53
    v_perm_b32 v86, v230, v226, s52
    v_perm_b32 v90, v230, v226, s53
    v_perm_b32 v87, v238, v234, s52
    v_perm_b32 v91, v238, v234, s53
    v_perm_b32 v92, v215, v211, s52
    v_perm_b32 v96, v215, v211, s53
    v_perm_b32 v93, v223, v219, s52
    v_perm_b32 v97, v223, v219, s53
    v_perm_b32 v94, v231, v227, s52
    v_perm_b32 v98, v231, v227, s53
    v_perm_b32 v95, v239, v235, s52
    v_perm_b32 v99, v239, v235, s53
    buffer_load_dwordx4 v[208:211], v2, s[24:27], s58 offen offset:0 nt
    buffer_load_dwordx4 v[212:215], v2, s[24:27], s58 offen offset:1024 nt
    buffer_load_dwordx4 v[216:219], v2, s[24:27], s58 offen offset:2048 nt
    buffer_load_dwordx4 v[220:223], v2, s[24:27], s58 offen offset:3072 nt
    buffer_load_dwordx4 v[224:227], v2, s[24:27], s59 offen offset:0 nt
    buffer_load_dwordx4 v[228:231], v2, s[24:27], s59 offen offset:1024 nt
    buffer_load_dwordx4 v[232:235], v2, s[24:27], s59 offen offset:2048 nt
    buffer_load_dwordx4 v[236:239], v2, s[24:27], s59 offen offset:3072 nt
    s_cmp_lg_u32 s60, 4
    s_cbranch_scc1 L_notag1
    buffer_load_dwordx2 v[108:109], off, s[72:75], 0 sc1
L_notag1:
    s_lshl_b32 s63, s60, 11
    s_cmp_lt_u32 s60, s47
    s_cselect_b32 s63, s63, 0
    s_cselect_b32 s56, 3, 0
    s_add_u32 s61, s63, 1024
    s_load_dword s36, s[48:49], s63
    s_load_dword s37, s[48:49], s61
    s_add_u32 s60, s60, 1
L_nomask0_1:
    v_max3_f32 v6, v56, v57, v58
    v_max3_f32 v6, v6, v59, v60
    v_max3_f32 v6, v6, v61, v62
    v_max_f32 v6, v6, v63
    v_mov_b32 v7, v6
    s_nop 1
    v_permlane16_swap_b32 v6, v7
    v_max_f32 v6, v6, v7
    v_mov_b32 v7, v6
    s_nop 1
    v_permlane32_swap_b32 v6, v7
    v_max_f32 v6, v6, v7
    v_mul_f32 v6, s51, v6
    v_max_f32 v101, v4, v6
    v_sub_f32 v100, v4, v101
    v_exp_f32 v100, v100
    v_mov_b32 v4, v101
    v_fma_f32 v56, v56, s51, -v101
    v_fma_f32 v57, v57, s51, -v101
    v_fma_f32 v58, v58, s51, -v101
    v_fma_f32 v59, v59, s51, -v101
    v_fma_f32 v60, v60, s51, -v101
    v_fma_f32 v61, v61, s51, -v101
    v_fma_f32 v62, v62, s51, -v101
    v_fma_f32 v63, v63, s51, -v101
    v_exp_f32 v56, v56
    v_exp_f32 v57, v57
    v_exp_f32 v58, v58
    v_exp_f32 v59, v59
    v_exp_f32 v60, v60
    v_exp_f32 v61, v61
    v_exp_f32 v62, v62
    v_exp_f32 v63, v63
    v_mul_f32 v24, v100, v24
    v_mul_f32 v25, v100, v25
    v_mul_f32 v26, v100, v26
    v_mul_f32 v27, v100, v27
    v_mul_f32 v28, v100, v28
    v_mul_f32 v29, v100, v29
    v_mul_f32 v30, v100, v30
    v_mul_f32 v31, v100, v31
    v_mul_f32 v32, v100, v32
    v_mul_f32 v33, v100, v33
    v_mul_f32 v34, v100, v34
    v_mul_f32 v35, v100, v35
    v_mul_f32 v36, v100, v36
    v_mul_f32 v37, v100, v37
    v_mul_f32 v38, v100, v38
    v_mul_f32 v39, v100, v39
    v_mul_f32 v40, v100, v40
    v_mul_f32 v41, v100, v41
    v_mul_f32 v42, v100, v42
    v_mul_f32 v43, v100, v43
    v_mul_f32 v44, v100, v44
    v_mul_f32 v45, v100, v45
    v_mul_f32 v46, v100, v46
    v_mul_f32 v47, v100, v47
    v_mul_f32 v48, v100, v48
    v_mul_f32 v49, v100, v49
    v_mul_f32 v50, v100, v50
    v_mul_f32 v51, v100, v51
    v_mul_f32 v52, v100, v52
    v_mul_f32 v53, v100, v53
    v_mul_f32 v54, v100, v54
    v_mul_f32 v55, v100, v55
    v_mul_f32 v5, v100, v5
    v_add_f32 v7, v56, v57
    v_add_f32 v102, v58, v59
    v_add_f32 v103, v60, v61
    v_add_f32 v6, v62, v63
    v_cvt_pk_bf16_f32 v64, v56, v57
    v_cvt_pk_bf16_f32 v65, v58, v59
    v_cvt_pk_bf16_f32 v66, v60, v61
    v_cvt_pk_bf16_f32 v67, v62, v63
    v_add_f32 v7, v7, v102
    v_add_f32 v103, v103, v6
    v_add_f32 v7, v7, v103
    v_add_f32 v5, v5, v7
    v_mfma_f32_16x16x32_bf16 v[24:27], v[68:71], v[64:67], v[24:27]
    v_mfma_f32_16x16x32_bf16 v[28:31], v[72:75], v[64:67], v[28:31]
    v_mfma_f32_16x16x32_bf16 v[32:35], v[76:79], v[64:67], v[32:35]
    v_mfma_f32_16x16x32_bf16 v[36:39], v[80:83], v[64:67], v[36:39]
    v_mfma_f32_16x16x32_bf16 v[40:43], v[84:87], v[64:67], v[40:43]
    v_mfma_f32_16x16x32_bf16 v[44:47], v[88:91], v[64:67], v[44:47]
    v_mfma_f32_16x16x32_bf16 v[48:51], v[92:95], v[64:67], v[48:51]
    v_mfma_f32_16x16x32_bf16 v[52:55], v[96:99], v[64:67], v[52:55]
    s_mov_b32 s55, s57
    s_branch L_tile0_0
L_tile1_0:
    s_waitcnt vmcnt(24)
    v_mfma_f32_16x16x32_bf16 v[56:59], v[112:115], v[8:11], 0
    v_mfma_f32_16x16x32_bf16 v[60:63], v[128:131], v[8:11], 0
    v_mfma_f32_16x16x32_bf16 v[56:59], v[116:119], v[12:15], v[56:59]
    v_mfma_f32_16x16x32_bf16 v[60:63], v[132:135], v[12:15], v[60:63]
    v_mfma_f32_16x16x32_bf16 v[56:59], v[120:123], v[16:19], v[56:59]
    v_mfma_f32_16x16x32_bf16 v[60:63], v[136:139], v[16:19], v[60:63]
    v_mfma_f32_16x16x32_bf16 v[56:59], v[124:127], v[20:23], v[56:59]
    v_mfma_f32_16x16x32_bf16 v[60:63], v[140:143], v[20:23], v[60:63]
    s_nop 7
    s_nop 7
L_nomask1_0:
    v_max3_f32 v6, v56, v57, v58
    v_max3_f32 v6, v6, v59, v60
    v_max3_f32 v6, v6, v61, v62
    v_max_f32 v6, v6, v63
    v_mov_b32 v7, v6
    s_nop 1
    v_permlane16_swap_b32 v6, v7
    v_max_f32 v6, v6, v7
    v_mov_b32 v7, v6
    s_nop 1
    v_permlane32_swap_b32 v6, v7
    v_max_f32 v6, v6, v7
    v_mul_f32 v6, s51, v6
    v_max_f32 v101, v4, v6
    v_sub_f32 v100, v4, v101
    v_exp_f32 v100, v100
    v_mov_b32 v4, v101
    v_fma_f32 v56, v56, s51, -v101
    v_fma_f32 v57, v57, s51, -v101
    v_fma_f32 v58, v58, s51, -v101
    v_fma_f32 v59, v59, s51, -v101
    v_fma_f32 v60, v60, s51, -v101
    v_fma_f32 v61, v61, s51, -v101
    v_fma_f32 v62, v62, s51, -v101
    v_fma_f32 v63, v63, s51, -v101
    v_exp_f32 v56, v56
    v_exp_f32 v57, v57
    v_exp_f32 v58, v58
    v_exp_f32 v59, v59
    v_exp_f32 v60, v60
    v_exp_f32 v61, v61
    v_exp_f32 v62, v62
    v_exp_f32 v63, v63
    v_mul_f32 v24, v100, v24
    v_mul_f32 v25, v100, v25
    v_mul_f32 v26, v100, v26
    v_mul_f32 v27, v100, v27
    v_mul_f32 v28, v100, v28
    v_mul_f32 v29, v100, v29
    v_mul_f32 v30, v100, v30
    v_mul_f32 v31, v100, v31
    v_mul_f32 v32, v100, v32
    v_mul_f32 v33, v100, v33
    v_mul_f32 v34, v100, v34
    v_mul_f32 v35, v100, v35
    v_mul_f32 v36, v100, v36
    v_mul_f32 v37, v100, v37
    v_mul_f32 v38, v100, v38
    v_mul_f32 v39, v100, v39
    v_mul_f32 v40, v100, v40
    v_mul_f32 v41, v100, v41
    v_mul_f32 v42, v100, v42
    v_mul_f32 v43, v100, v43
    v_mul_f32 v44, v100, v44
    v_mul_f32 v45, v100, v45
    v_mul_f32 v46, v100, v46
    v_mul_f32 v47, v100, v47
    v_mul_f32 v48, v100, v48
    v_mul_f32 v49, v100, v49
    v_mul_f32 v50, v100, v50
    v_mul_f32 v51, v100, v51
    v_mul_f32 v52, v100, v52
    v_mul_f32 v53, v100, v53
    v_mul_f32 v54, v100, v54
    v_mul_f32 v55, v100, v55
    v_mul_f32 v5, v100, v5
    v_add_f32 v7, v56, v57
    v_add_f32 v102, v58, v59
    v_add_f32 v103, v60, v61
    v_add_f32 v6, v62, v63
    v_cvt_pk_bf16_f32 v64, v56, v57
    v_cvt_pk_bf16_f32 v65, v58, v59
    v_cvt_pk_bf16_f32 v66, v60, v61
    v_cvt_pk_bf16_f32 v67, v62, v63
    v_add_f32 v7, v7, v102
    v_add_f32 v103, v103, v6
    v_add_f32 v7, v7, v103
    v_add_f32 v5, v5, v7
    s_waitcnt vmcnt(16)
    v_perm_b32 v68, v148, v144, s52
    v_perm_b32 v72, v148, v144, s53
    v_perm_b32 v69, v156, v152, s52
    v_perm_b32 v73, v156, v152, s53
    v_perm_b32 v70, v164, v160, s52
    v_perm_b32 v74, v164, v160, s53
    v_perm_b32 v71, v172, v168, s52
    v_perm_b32 v75, v172, v168, s53
    v_perm_b32 v76, v149, v145, s52
    v_perm_b32 v80, v149, v145, s53
    v_perm_b32 v77, v157, v153, s52
    v_perm_b32 v81, v157, v153, s53
    v_perm_b32 v78, v165, v161, s52
    v_perm_b32 v82, v165, v161, s53
    v_perm_b32 v79, v173, v169, s52
    v_perm_b32 v83, v173, v169, s53
    v_mfma_f32_16x16x32_bf16 v[24:27], v[68:71], v[64:67], v[24:27]
    v_mfma_f32_16x16x32_bf16 v[28:31], v[72:75], v[64:67], v[28:31]
    v_perm_b32 v84, v150, v146, s52
    v_perm_b32 v88, v150, v146, s53
    v_perm_b32 v85, v158, v154, s52
    v_perm_b32 v89, v158, v154, s53
    v_perm_b32 v86, v166, v162, s52
    v_perm_b32 v90, v166, v162, s53
    v_perm_b32 v87, v174, v170, s52
    v_perm_b32 v91, v174, v170, s53
    v_mfma_f32_16x16x32_bf16 v[32:35], v[76:79], v[64:67], v[32:35]
    v_mfma_f32_16x16x32_bf16 v[36:39], v[80:83], v[64:67], v[36:39]
    v_perm_b32 v92, v151, v147, s52
    v_perm_b32 v96, v151, v147, s53
    v_perm_b32 v93, v159, v155, s52
    v_perm_b32 v97, v159, v155, s53
    v_perm_b32 v94, v167, v163, s52
    v_perm_b32 v98, v167, v163, s53
    v_perm_b32 v95, v175, v171, s52
    v_perm_b32 v99, v175, v171, s53
    v_mfma_f32_16x16x32_bf16 v[40:43], v[84:87], v[64:67], v[40:43]
    v_mfma_f32_16x16x32_bf16 v[44:47], v[88:91], v[64:67], v[44:47]
    s_nop 1
    v_mfma_f32_16x16x32_bf16 v[48:51], v[92:95], v[64:67], v[48:51]
    v_mfma_f32_16x16x32_bf16 v[52:55], v[96:99], v[64:67], v[52:55]
    s_cmp_lt_i32 s55, 1
    s_cbranch_scc1 L_epi
    s_branch L_tile2_1
L_tile1_1:
    s_waitcnt vmcnt(24)
    v_mfma_f32_16x16x32_bf16 v[56:59], v[176:179], v[8:11], 0
    v_mfma_f32_16x16x32_bf16 v[60:63], v[192:195], v[8:11], 0
    v_mfma_f32_16x16x32_bf16 v[56:59], v[180:183], v[12:15], v[56:59]
    v_mfma_f32_16x16x32_bf16 v[60:63], v[196:199], v[12:15], v[60:63]
    v_mfma_f32_16x16x32_bf16 v[56:59], v[184:187], v[16:19], v[56:59]
    v_mfma_f32_16x16x32_bf16 v[60:63], v[200:203], v[16:19], v[60:63]
    v_mfma_f32_16x16x32_bf16 v[56:59], v[188:191], v[20:23], v[56:59]
    v_mfma_f32_16x16x32_bf16 v[60:63], v[204:207], v[20:23], v[60:63]
    s_nop 7
    s_nop 7
L_nomask1_1:
    v_max3_f32 v6, v56, v57, v58
    v_max3_f32 v6, v6, v59, v60
    v_max3_f32 v6, v6, v61, v62
    v_max_f32 v6, v6, v63
    v_mov_b32 v7, v6
    s_nop 1
    v_permlane16_swap_b32 v6, v7
    v_max_f32 v6, v6, v7
    v_mov_b32 v7, v6
    s_nop 1
    v_permlane32_swap_b32 v6, v7
    v_max_f32 v6, v6, v7
    v_mul_f32 v6, s51, v6
    v_max_f32 v101, v4, v6
    v_sub_f32 v100, v4, v101
    v_exp_f32 v100, v100
    v_mov_b32 v4, v101
    v_fma_f32 v56, v56, s51, -v101
    v_fma_f32 v57, v57, s51, -v101
    v_fma_f32 v58, v58, s51, -v101
    v_fma_f32 v59, v59, s51, -v101
    v_fma_f32 v60, v60, s51, -v101
    v_fma_f32 v61, v61, s51, -v101
    v_fma_f32 v62, v62, s51, -v101
    v_fma_f32 v63, v63, s51, -v101
    v_exp_f32 v56, v56
    v_exp_f32 v57, v57
    v_exp_f32 v58, v58
    v_exp_f32 v59, v59
    v_exp_f32 v60, v60
    v_exp_f32 v61, v61
    v_exp_f32 v62, v62
    v_exp_f32 v63, v63
    v_mul_f32 v24, v100, v24
    v_mul_f32 v25, v100, v25
    v_mul_f32 v26, v100, v26
    v_mul_f32 v27, v100, v27
    v_mul_f32 v28, v100, v28
    v_mul_f32 v29, v100, v29
    v_mul_f32 v30, v100, v30
    v_mul_f32 v31, v100, v31
    v_mul_f32 v32, v100, v32
    v_mul_f32 v33, v100, v33
    v_mul_f32 v34, v100, v34
    v_mul_f32 v35, v100, v35
    v_mul_f32 v36, v100, v36
    v_mul_f32 v37, v100, v37
    v_mul_f32 v38, v100, v38
    v_mul_f32 v39, v100, v39
    v_mul_f32 v40, v100, v40
    v_mul_f32 v41, v100, v41
    v_mul_f32 v42, v100, v42
    v_mul_f32 v43, v100, v43
    v_mul_f32 v44, v100, v44
    v_mul_f32 v45, v100, v45
    v_mul_f32 v46, v100, v46
    v_mul_f32 v47, v100, v47
    v_mul_f32 v48, v100, v48
    v_mul_f32 v49, v100, v49
    v_mul_f32 v50, v100, v50
    v_mul_f32 v51, v100, v51
    v_mul_f32 v52, v100, v52
    v_mul_f32 v53, v100, v53
    v_mul_f32 v54, v100, v54
    v_mul_f32 v55, v100, v55
    v_mul_f32 v5, v100, v5
    v_add_f32 v7, v56, v57
    v_add_f32 v102, v58, v59
    v_add_f32 v103, v60, v61
    v_add_f32 v6, v62, v63
    v_cvt_pk_bf16_f32 v64, v56, v57
    v_cvt_pk_bf16_f32 v65, v58, v59
    v_cvt_pk_bf16_f32 v66, v60, v61
    v_cvt_pk_bf16_f32 v67, v62, v63
    v_add_f32 v7, v7, v102
    v_add_f32 v103, v103, v6
    v_add_f32 v7, v7, v103
    v_add_f32 v5, v5, v7
    s_waitcnt vmcnt(16)
    v_perm_b32 v68, v212, v208, s52
    v_perm_b32 v72, v212, v208, s53
    v_perm_b32 v69, v220, v216, s52
    v_perm_b32 v73, v220, v216, s53
    v_perm_b32 v70, v228, v224, s52
    v_perm_b32 v74, v228, v224, s53
    v_perm_b32 v71, v236, v232, s52
    v_perm_b32 v75, v236, v232, s53
    v_perm_b32 v76, v213, v209, s52
    v_perm_b32 v80, v213, v209, s53
    v_perm_b32 v77, v221, v217, s52
    v_perm_b32 v81, v221, v217, s53
    v_perm_b32 v78, v229, v225, s52
    v_perm_b32 v82, v229, v225, s53
    v_perm_b32 v79, v237, v233, s52
    v_perm_b32 v83, v237, v233, s53
    v_mfma_f32_16x16x32_bf16 v[24:27], v[68:71], v[64:67], v[24:27]
    v_mfma_f32_16x16x32_bf16 v[28:31], v[72:75], v[64:67], v[28:31]
    v_perm_b32 v84, v214, v210, s52
    v_perm_b32 v88, v214, v210, s53
    v_perm_b32 v85, v222, v218, s52
    v_perm_b32 v89, v222, v218, s53
    v_perm_b32 v86, v230, v226, s52
    v_perm_b32 v90, v230, v226, s53
    v_perm_b32 v87, v238, v234, s52
    v_perm_b32 v91, v238, v234, s53
    v_mfma_f32_16x16x32_bf16 v[32:35], v[76:79], v[64:67], v[32:35]
    v_mfma_f32_16x16x32_bf16 v[36:39], v[80:83], v[64:67], v[36:39]
    v_perm_b32 v92, v215, v211, s52
    v_perm_b32 v96, v215, v211, s53
    v_perm_b32 v93, v223, v219, s52
    v_perm_b32 v97, v223, v219, s53
    v_perm_b32 v94, v231, v227, s52
    v_perm_b32 v98, v231, v227, s53
    v_perm_b32 v95, v239, v235, s52
    v_perm_b32 v99, v239, v235, s53
    v_mfma_f32_16x16x32_bf16 v[40:43], v[84:87], v[64:67], v[40:43]
    v_mfma_f32_16x16x32_bf16 v[44:47], v[88:91], v[64:67], v[44:47]
    s_nop 1
    v_mfma_f32_16x16x32_bf16 v[48:51], v[92:95], v[64:67], v[48:51]
    v_mfma_f32_16x16x32_bf16 v[52:55], v[96:99], v[64:67], v[52:55]
    s_cmp_lt_i32 s54, 1
    s_cbranch_scc1 L_epi
    s_branch L_tile2_0
L_tile2_0:
    s_waitcnt vmcnt(8)
    v_mfma_f32_16x16x32_bf16 v[56:59], v[112:115], v[8:11], 0
    v_mfma_f32_16x16x32_bf16 v[60:63], v[128:131], v[8:11], 0
    v_mfma_f32_16x16x32_bf16 v[56:59], v[116:119], v[12:15], v[56:59]
    v_mfma_f32_16x16x32_bf16 v[60:63], v[132:135], v[12:15], v[60:63]
    v_mfma_f32_16x16x32_bf16 v[56:59], v[120:123], v[16:19], v[56:59]
    v_mfma_f32_16x16x32_bf16 v[60:63], v[136:139], v[16:19], v[60:63]
    v_mfma_f32_16x16x32_bf16 v[56:59], v[124:127], v[20:23], v[56:59]
    v_mfma_f32_16x16x32_bf16 v[60:63], v[140:143], v[20:23], v[60:63]
    s_nop 7
    s_nop 7
L_nomask2_0:
    v_max3_f32 v6, v56, v57, v58
    v_max3_f32 v6, v6, v59, v60
    v_max3_f32 v6, v6, v61, v62
    v_max_f32 v6, v6, v63
    v_mov_b32 v7, v6
    s_nop 1
    v_permlane16_swap_b32 v6, v7
    v_max_f32 v6, v6, v7
    v_mov_b32 v7, v6
    s_nop 1
    v_permlane32_swap_b32 v6, v7
    v_max_f32 v6, v6, v7
    v_mul_f32 v6, s51, v6
    v_max_f32 v101, v4, v6
    v_sub_f32 v100, v4, v101
    v_exp_f32 v100, v100
    v_mov_b32 v4, v101
    v_fma_f32 v56, v56, s51, -v101
    v_fma_f32 v57, v57, s51, -v101
    v_fma_f32 v58, v58, s51, -v101
    v_fma_f32 v59, v59, s51, -v101
    v_fma_f32 v60, v60, s51, -v101
    v_fma_f32 v61, v61, s51, -v101
    v_fma_f32 v62, v62, s51, -v101
    v_fma_f32 v63, v63, s51, -v101
    v_exp_f32 v56, v56
    v_exp_f32 v57, v57
    v_exp_f32 v58, v58
    v_exp_f32 v59, v59
    v_exp_f32 v60, v60
    v_exp_f32 v61, v61
    v_exp_f32 v62, v62
    v_exp_f32 v63, v63
    v_mul_f32 v24, v100, v24
    v_mul_f32 v25, v100, v25
    v_mul_f32 v26, v100, v26
    v_mul_f32 v27, v100, v27
    v_mul_f32 v28, v100, v28
    v_mul_f32 v29, v100, v29
    v_mul_f32 v30, v100, v30
    v_mul_f32 v31, v100, v31
    v_mul_f32 v32, v100, v32
    v_mul_f32 v33, v100, v33
    v_mul_f32 v34, v100, v34
    v_mul_f32 v35, v100, v35
    v_mul_f32 v36, v100, v36
    v_mul_f32 v37, v100, v37
    v_mul_f32 v38, v100, v38
    v_mul_f32 v39, v100, v39
    v_mul_f32 v40, v100, v40
    v_mul_f32 v41, v100, v41
    v_mul_f32 v42, v100, v42
    v_mul_f32 v43, v100, v43
    v_mul_f32 v44, v100, v44
    v_mul_f32 v45, v100, v45
    v_mul_f32 v46, v100, v46
    v_mul_f32 v47, v100, v47
    v_mul_f32 v48, v100, v48
    v_mul_f32 v49, v100, v49
    v_mul_f32 v50, v100, v50
    v_mul_f32 v51, v100, v51
    v_mul_f32 v52, v100, v52
    v_mul_f32 v53, v100, v53
    v_mul_f32 v54, v100, v54
    v_mul_f32 v55, v100, v55
    v_mul_f32 v5, v100, v5
    v_add_f32 v7, v56, v57
    v_add_f32 v102, v58, v59
    v_add_f32 v103, v60, v61
    v_add_f32 v6, v62, v63
    v_cvt_pk_bf16_f32 v64, v56, v57
    v_cvt_pk_bf16_f32 v65, v58, v59
    v_cvt_pk_bf16_f32 v66, v60, v61
    v_cvt_pk_bf16_f32 v67, v62, v63
    v_add_f32 v7, v7, v102
    v_add_f32 v103, v103, v6
    v_add_f32 v7, v7, v103
    v_add_f32 v5, v5, v7
    s_waitcnt vmcnt(0)
    v_perm_b32 v68, v148, v144, s52
    v_perm_b32 v72, v148, v144, s53
    v_perm_b32 v69, v156, v152, s52
    v_perm_b32 v73, v156, v152, s53
    v_perm_b32 v70, v164, v160, s52
    v_perm_b32 v74, v164, v160, s53
    v_perm_b32 v71, v172, v168, s52
    v_perm_b32 v75, v172, v168, s53
    v_perm_b32 v76, v149, v145, s52
    v_perm_b32 v80, v149, v145, s53
    v_perm_b32 v77, v157, v153, s52
    v_perm_b32 v81, v157, v153, s53
    v_perm_b32 v78, v165, v161, s52
    v_perm_b32 v82, v165, v161, s53
    v_perm_b32 v79, v173, v169, s52
    v_perm_b32 v83, v173, v169, s53
    v_mfma_f32_16x16x32_bf16 v[24:27], v[68:71], v[64:67], v[24:27]
    v_mfma_f32_16x16x32_bf16 v[28:31], v[72:75], v[64:67], v[28:31]
    v_perm_b32 v84, v150, v146, s52
    v_perm_b32 v88, v150, v146, s53
    v_perm_b32 v85, v158, v154, s52
    v_perm_b32 v89, v158, v154, s53
    v_perm_b32 v86, v166, v162, s52
    v_perm_b32 v90, v166, v162, s53
    v_perm_b32 v87, v174, v170, s52
    v_perm_b32 v91, v174, v170, s53
    v_mfma_f32_16x16x32_bf16 v[32:35], v[76:79], v[64:67], v[32:35]
    v_mfma_f32_16x16x32_bf16 v[36:39], v[80:83], v[64:67], v[36:39]
    v_perm_b32 v92, v151, v147, s52
    v_perm_b32 v96, v151, v147, s53
    v_perm_b32 v93, v159, v155, s52
    v_perm_b32 v97, v159, v155, s53
    v_perm_b32 v94, v167, v163, s52
    v_perm_b32 v98, v167, v163, s53
    v_perm_b32 v95, v175, v171, s52
    v_perm_b32 v99, v175, v171, s53
    v_mfma_f32_16x16x32_bf16 v[40:43], v[84:87], v[64:67], v[40:43]
    v_mfma_f32_16x16x32_bf16 v[44:47], v[88:91], v[64:67], v[44:47]
    s_nop 1
    v_mfma_f32_16x16x32_bf16 v[48:51], v[92:95], v[64:67], v[48:51]
    v_mfma_f32_16x16x32_bf16 v[52:55], v[96:99], v[64:67], v[52:55]
    s_branch L_epi
L_tile2_1:
    s_waitcnt vmcnt(8)
    v_mfma_f32_16x16x32_bf16 v[56:59], v[176:179], v[8:11], 0
    v_mfma_f32_16x16x32_bf16 v[60:63], v[192:195], v[8:11], 0
    v_mfma_f32_16x16x32_bf16 v[56:59], v[180:183], v[12:15], v[56:59]
    v_mfma_f32_16x16x32_bf16 v[60:63], v[196:199], v[12:15], v[60:63]
    v_mfma_f32_16x16x32_bf16 v[56:59], v[184:187], v[16:19], v[56:59]
    v_mfma_f32_16x16x32_bf16 v[60:63], v[200:203], v[16:19], v[60:63]
    v_mfma_f32_16x16x32_bf16 v[56:59], v[188:191], v[20:23], v[56:59]
    v_mfma_f32_16x16x32_bf16 v[60:63], v[204:207], v[20:23], v[60:63]
    s_nop 7
    s_nop 7
L_nomask2_1:
    v_max3_f32 v6, v56, v57, v58
    v_max3_f32 v6, v6, v59, v60
    v_max3_f32 v6, v6, v61, v62
    v_max_f32 v6, v6, v63
    v_mov_b32 v7, v6
    s_nop 1
    v_permlane16_swap_b32 v6, v7
    v_max_f32 v6, v6, v7
    v_mov_b32 v7, v6
    s_nop 1
    v_permlane32_swap_b32 v6, v7
    v_max_f32 v6, v6, v7
    v_mul_f32 v6, s51, v6
    v_max_f32 v101, v4, v6
    v_sub_f32 v100, v4, v101
    v_exp_f32 v100, v100
    v_mov_b32 v4, v101
    v_fma_f32 v56, v56, s51, -v101
    v_fma_f32 v57, v57, s51, -v101
    v_fma_f32 v58, v58, s51, -v101
    v_fma_f32 v59, v59, s51, -v101
    v_fma_f32 v60, v60, s51, -v101
    v_fma_f32 v61, v61, s51, -v101
    v_fma_f32 v62, v62, s51, -v101
    v_fma_f32 v63, v63, s51, -v101
    v_exp_f32 v56, v56
    v_exp_f32 v57, v57
    v_exp_f32 v58, v58
    v_exp_f32 v59, v59
    v_exp_f32 v60, v60
    v_exp_f32 v61, v61
    v_exp_f32 v62, v62
    v_exp_f32 v63, v63
    v_mul_f32 v24, v100, v24
    v_mul_f32 v25, v100, v25
    v_mul_f32 v26, v100, v26
    v_mul_f32 v27, v100, v27
    v_mul_f32 v28, v100, v28
    v_mul_f32 v29, v100, v29
    v_mul_f32 v30, v100, v30
    v_mul_f32 v31, v100, v31
    v_mul_f32 v32, v100, v32
    v_mul_f32 v33, v100, v33
    v_mul_f32 v34, v100, v34
    v_mul_f32 v35, v100, v35
    v_mul_f32 v36, v100, v36
    v_mul_f32 v37, v100, v37
    v_mul_f32 v38, v100, v38
    v_mul_f32 v39, v100, v39
    v_mul_f32 v40, v100, v40
    v_mul_f32 v41, v100, v41
    v_mul_f32 v42, v100, v42
    v_mul_f32 v43, v100, v43
    v_mul_f32 v44, v100, v44
    v_mul_f32 v45, v100, v45
    v_mul_f32 v46, v100, v46
    v_mul_f32 v47, v100, v47
    v_mul_f32 v48, v100, v48
    v_mul_f32 v49, v100, v49
    v_mul_f32 v50, v100, v50
    v_mul_f32 v51, v100, v51
    v_mul_f32 v52, v100, v52
    v_mul_f32 v53, v100, v53
    v_mul_f32 v54, v100, v54
    v_mul_f32 v55, v100, v55
    v_mul_f32 v5, v100, v5
    v_add_f32 v7, v56, v57
    v_add_f32 v102, v58, v59
    v_add_f32 v103, v60, v61
    v_add_f32 v6, v62, v63
    v_cvt_pk_bf16_f32 v64, v56, v57
    v_cvt_pk_bf16_f32 v65, v58, v59
    v_cvt_pk_bf16_f32 v66, v60, v61
    v_cvt_pk_bf16_f32 v67, v62, v63
    v_add_f32 v7, v7, v102
    v_add_f32 v103, v103, v6
    v_add_f32 v7, v7, v103
    v_add_f32 v5, v5, v7
    s_waitcnt vmcnt(0)
    v_perm_b32 v68, v212, v208, s52
    v_perm_b32 v72, v212, v208, s53
    v_perm_b32 v69, v220, v216, s52
    v_perm_b32 v73, v220, v216, s53
    v_perm_b32 v70, v228, v224, s52
    v_perm_b32 v74, v228, v224, s53
    v_perm_b32 v71, v236, v232, s52
    v_perm_b32 v75, v236, v232, s53
    v_perm_b32 v76, v213, v209, s52
    v_perm_b32 v80, v213, v209, s53
    v_perm_b32 v77, v221, v217, s52
    v_perm_b32 v81, v221, v217, s53
    v_perm_b32 v78, v229, v225, s52
    v_perm_b32 v82, v229, v225, s53
    v_perm_b32 v79, v237, v233, s52
    v_perm_b32 v83, v237, v233, s53
    v_mfma_f32_16x16x32_bf16 v[24:27], v[68:71], v[64:67], v[24:27]
    v_mfma_f32_16x16x32_bf16 v[28:31], v[72:75], v[64:67], v[28:31]
    v_perm_b32 v84, v214, v210, s52
    v_perm_b32 v88, v214, v210, s53
    v_perm_b32 v85, v222, v218, s52
    v_perm_b32 v89, v222, v218, s53
    v_perm_b32 v86, v230, v226, s52
    v_perm_b32 v90, v230, v226, s53
    v_perm_b32 v87, v238, v234, s52
    v_perm_b32 v91, v238, v234, s53
    v_mfma_f32_16x16x32_bf16 v[32:35], v[76:79], v[64:67], v[32:35]
    v_mfma_f32_16x16x32_bf16 v[36:39], v[80:83], v[64:67], v[36:39]
    v_perm_b32 v92, v215, v211, s52
    v_perm_b32 v96, v215, v211, s53
    v_perm_b32 v93, v223, v219, s52
    v_perm_b32 v97, v223, v219, s53
    v_perm_b32 v94, v231, v227, s52
    v_perm_b32 v98, v231, v227, s53
    v_perm_b32 v95, v239, v235, s52
    v_perm_b32 v99, v239, v235, s53
    v_mfma_f32_16x16x32_bf16 v[40:43], v[84:87], v[64:67], v[40:43]
    v_mfma_f32_16x16x32_bf16 v[44:47], v[88:91], v[64:67], v[44:47]
    s_nop 1
    v_mfma_f32_16x16x32_bf16 v[48:51], v[92:95], v[64:67], v[48:51]
    v_mfma_f32_16x16x32_bf16 v[52:55], v[96:99], v[64:67], v[52:55]
    s_branch L_epi
L_epi:
    s_waitcnt lgkmcnt(0)
    s_mov_b32 s41, 0
L_tagwait:
    s_waitcnt vmcnt(0)
    v_readfirstlane_b32 s61, v109
    s_cmp_lg_u32 s61, 0
    s_cbranch_scc1 L_tagok
    s_add_u32 s41, s41, 1
    s_cmp_gt_u32 s41, 0x40000
    s_cbranch_scc1 L_tagok
    s_sleep 1
    buffer_load_dwordx2 v[108:109], off, s[72:75], 0 sc1
    s_branch L_tagwait
L_tagok:
    v_mov_b32 v7, v5
    v_max3_f32 v6, |v24|, |v25|, |v26|
    v_max3_f32 v102, |v39|, |v40|, |v41|
    v_permlane16_swap_b32 v5, v7
    v_add_f32 v5, v5, v7
    v_mov_b32 v7, v5
    v_max3_f32 v6, |v27|, |v28|, v6
    v_max3_f32 v102, |v42|, |v43|, v102
    v_permlane32_swap_b32 v5, v7
    v_add_f32 v5, v5, v7
    v_max3_f32 v6, |v29|, |v30|, v6
    v_max3_f32 v102, |v44|, |v45|, v102
    v_max3_f32 v6, |v31|, |v32|, v6
    v_max3_f32 v102, |v46|, |v47|, v102
    v_max3_f32 v6, |v33|, |v34|, v6
    v_max3_f32 v102, |v48|, |v49|, v102
    v_max3_f32 v6, |v35|, |v36|, v6
    v_max3_f32 v102, |v50|, |v51|, v102
    v_max3_f32 v6, |v37|, |v38|, v6
    v_max3_f32 v102, |v52|, |v53|, v102
    v_max3_f32 v102, |v54|, |v55|, v102
    v_max3_f32 v6, v6, s66, v102
    v_mov_b32 v7, v6
    v_mov_b32 v57, v108
    v_mov_b32 v59, v108
    v_permlane16_swap_b32 v6, v7
    v_max_f32 v6, v6, v7
    v_mov_b32 v7, v6
    v_lshrrev_b32 v103, v243, v108
    s_nop 0
    v_permlane32_swap_b32 v6, v7
    v_max_f32 v6, v6, v7
    v_and_b32 v6, 0x7f800000, v6
    v_sub_u32 v100, 0x84fff800, v6
    v_cvt_f32_u32 v7, v6
    v_mul_f32 v58, v5, v100
    v_fma_f32 v56, v7, s67, v4
    s_mov_b64 exec, 0xff
    buffer_store_dwordx4 v[56:59], v242, s[32:35], s5 offen sc1
    s_mov_b64 exec, s[68:69]
    v_pk_fma_f32 v[24:25], v[24:25], v[100:101], s[64:65] op_sel_hi:[1,0,1]
    v_pk_fma_f32 v[26:27], v[26:27], v[100:101], s[64:65] op_sel_hi:[1,0,1]
    v_pk_fma_f32 v[28:29], v[28:29], v[100:101], s[64:65] op_sel_hi:[1,0,1]
    v_pk_fma_f32 v[30:31], v[30:31], v[100:101], s[64:65] op_sel_hi:[1,0,1]
    v_pk_fma_f32 v[32:33], v[32:33], v[100:101], s[64:65] op_sel_hi:[1,0,1]
    v_pk_fma_f32 v[34:35], v[34:35], v[100:101], s[64:65] op_sel_hi:[1,0,1]
    v_pk_fma_f32 v[36:37], v[36:37], v[100:101], s[64:65] op_sel_hi:[1,0,1]
    v_pk_fma_f32 v[38:39], v[38:39], v[100:101], s[64:65] op_sel_hi:[1,0,1]
    v_pk_fma_f32 v[40:41], v[40:41], v[100:101], s[64:65] op_sel_hi:[1,0,1]
    v_pk_fma_f32 v[42:43], v[42:43], v[100:101], s[64:65] op_sel_hi:[1,0,1]
    v_pk_fma_f32 v[44:45], v[44:45], v[100:101], s[64:65] op_sel_hi:[1,0,1]
    v_pk_fma_f32 v[46:47], v[46:47], v[100:101], s[64:65] op_sel_hi:[1,0,1]
    v_pk_fma_f32 v[48:49], v[48:49], v[100:101], s[64:65] op_sel_hi:[1,0,1]
    v_pk_fma_f32 v[50:51], v[50:51], v[100:101], s[64:65] op_sel_hi:[1,0,1]
    v_pk_fma_f32 v[52:53], v[52:53], v[100:101], s[64:65] op_sel_hi:[1,0,1]
    v_pk_fma_f32 v[54:55], v[54:55], v[100:101], s[64:65] op_sel_hi:[1,0,1]
    v_perm_b32 v68, v28, v24, s52
    v_perm_b32 v69, v36, v32, s52
    v_perm_b32 v70, v44, v40, s52
    v_perm_b32 v71, v52, v48, s52
    ds_write_b128 v240, v[68:71] offset:0
    v_perm_b32 v72, v29, v25, s52
    v_perm_b32 v73, v37, v33, s52
    v_perm_b32 v74, v45, v41, s52
    v_perm_b32 v75, v53, v49, s52
    ds_write_b128 v240, v[72:75] offset:16
    v_perm_b32 v76, v30, v26, s52
    v_perm_b32 v77, v38, v34, s52
    v_perm_b32 v78, v46, v42, s52
    v_perm_b32 v79, v54, v50, s52
    ds_write_b128 v240, v[76:79] offset:32
    v_perm_b32 v80, v31, v27, s52
    v_perm_b32 v81, v39, v35, s52
    v_perm_b32 v82, v47, v43, s52
    v_perm_b32 v83, v55, v51, s52
    ds_write_b128 v240, v[80:83] offset:48
    s_mov_b64 exec, -1
    s_waitcnt lgkmcnt(0)
    ds_read_b128 v[84:87], v241 offset:0
    ds_read_b128 v[88:91], v241 offset:1088
    v_lshlrev_b32 v128, 14, v103
    v_lshlrev_b32 v129, 12, v103
    v_lshlrev_b32 v130, 10, v103
    v_lshlrev_b32 v131, 8, v103
    v_and_b32 v128, s12, v128
    v_and_b32 v129, s12, v129
    v_and_b32 v130, s12, v130
    v_and_b32 v131, s12, v131
    v_not_b32 v112, v128
    v_not_b32 v116, v128
    s_waitcnt lgkmcnt(1)
    v_or_b32 v84, v84, v128
    v_or_b32 v85, v85, v129
    v_or_b32 v86, v86, v130
    v_or_b32 v87, v87, v131
    buffer_store_dwordx4 v[84:87], v242, s[32:35], s4 offen offset:0 sc1
    s_waitcnt lgkmcnt(0)
    v_or_b32 v88, v88, v128
    v_or_b32 v89, v89, v129
    v_or_b32 v90, v90, v130
    v_or_b32 v91, v91, v131
    buffer_store_dwordx4 v[88:91], v242, s[32:35], s4 offen offset:1024 sc1
    s_mov_b64 s[54:55], -1
    s_mov_b64 s[56:57], -1
    s_mov_b64 s[52:53], -1
    s_mov_b32 s37, 12
    s_mov_b32 s41, 0
    s_barrier
L_poll:
    s_bcnt1_i32_b64 s40, s[52:53]
    s_cmp_le_u32 s40, s37
    s_mov_b32 s37, 12
    s_cselect_b64 s[42:43], 0, s[52:53]
    s_mov_b64 exec, s[52:53]
    s_cbranch_execz L_p_noml
    buffer_load_dwordx4 v[252:255], v244, s[32:35], s14 offen sc1
L_p_noml:
    s_lshr_b64 s[64:65], s[54:55], 1
    s_lshr_b64 s[62:63], s[42:43], 0
    s_or_b64 s[64:65], s[64:65], s[54:55]
    s_andn2_b64 s[62:63], s[64:65], s[62:63]
    s_and_b32 s62, s62, 0x55555555
    s_and_b32 s63, s63, 0x55555555
    s_mul_i32 exec_lo, s62, 3
    s_mul_i32 exec_hi, s63, 3
    s_cbranch_execz L_p_no0
    buffer_load_dwordx4 v[112:115], v245, s[32:35], s8 offen sc1
L_p_no0:
    s_lshr_b64 s[64:65], s[56:57], 1
    s_lshr_b64 s[62:63], s[42:43], 1
    s_or_b64 s[64:65], s[64:65], s[56:57]
    s_andn2_b64 s[62:63], s[64:65], s[62:63]
    s_and_b32 s62, s62, 0x55555555
    s_and_b32 s63, s63, 0x55555555
    s_mul_i32 exec_lo, s62, 3
    s_mul_i32 exec_hi, s63, 3
    s_cbranch_execz L_p_no1
    buffer_load_dwordx4 v[116:119], v245, s[32:35], s9 offen sc1
L_p_no1:
    s_mov_b64 exec, -1
    s_waitcnt vmcnt(0)
    v_cmp_ne_u32 s[52:53], v253, v108
    v_cmp_ne_u32 s[62:63], v255, v108
    v_xor_b32 v120, v112, v128
    v_xor_b32 v121, v113, v129
    v_xor_b32 v122, v114, v130
    v_xor_b32 v123, v115, v131
    v_xor_b32 v124, v116, v128
    v_xor_b32 v125, v117, v129
    v_xor_b32 v126, v118, v130
    v_xor_b32 v127, v119, v131
    v_or3_b32 v132, v120, v121, v122
    v_or3_b32 v133, v124, v125, v126
    v_or_b32 v132, v132, v123
    v_or_b32 v133, v133, v127
    v_and_b32 v132, s12, v132
    v_and_b32 v133, s12, v133
    v_cmp_ne_u32 s[54:55], 0, v132
    v_cmp_ne_u32 s[56:57], 0, v133
    s_or_b64 s[52:53], s[52:53], s[62:63]
    s_or_b64 s[62:63], s[54:55], s[56:57]
    s_or_b64 s[62:63], s[62:63], s[52:53]
    s_cbranch_scc0 L_polldone
    s_add_u32 s41, s41, 1
    s_cmp_gt_u32 s41, 0x20000
    s_cbranch_scc1 L_polldone
    s_cmp_le_u32 s40, 12
    s_cbranch_scc1 L_poll
    s_sleep 0
    s_branch L_poll
L_polldone:
    v_mov_b32 v132, v252
    v_cvt_f32_u32_sdwa v152, v120 dst_sel:DWORD dst_unused:UNUSED_PAD src0_sel:WORD_0
    v_cvt_f32_u32_sdwa v153, v120 dst_sel:DWORD dst_unused:UNUSED_PAD src0_sel:WORD_1
    v_max_f32_dpp v132, v132, v132 quad_perm:[1,0,3,2] row_mask:0xf bank_mask:0xf
    v_cvt_f32_u32_sdwa v154, v121 dst_sel:DWORD dst_unused:UNUSED_PAD src0_sel:WORD_0
    v_cvt_f32_u32_sdwa v155, v121 dst_sel:DWORD dst_unused:UNUSED_PAD src0_sel:WORD_1
    v_max_f32_dpp v132, v132, v132 quad_perm:[2,3,0,1] row_mask:0xf bank_mask:0xf
    v_cvt_f32_u32_sdwa v156, v122 dst_sel:DWORD dst_unused:UNUSED_PAD src0_sel:WORD_0
    v_cvt_f32_u32_sdwa v157, v122 dst_sel:DWORD dst_unused:UNUSED_PAD src0_sel:WORD_1
    v_max_f32_dpp v132, v132, v132 row_ror:4 row_mask:0xf bank_mask:0xf
    v_cvt_f32_u32_sdwa v158, v123 dst_sel:DWORD dst_unused:UNUSED_PAD src0_sel:WORD_0
    v_cvt_f32_u32_sdwa v159, v123 dst_sel:DWORD dst_unused:UNUSED_PAD src0_sel:WORD_1
    v_max_f32_dpp v132, v132, v132 row_ror:8 row_mask:0xf bank_mask:0xf
    v_mov_b32 v133, v132
    v_cvt_f32_u32_sdwa v160, v124 dst_sel:DWORD dst_unused:UNUSED_PAD src0_sel:WORD_0
    v_cvt_f32_u32_sdwa v161, v124 dst_sel:DWORD dst_unused:UNUSED_PAD src0_sel:WORD_1
    v_permlane16_swap_b32 v132, v133
    v_max_f32 v132, v132, v133
    v_mov_b32 v133, v132
    v_cvt_f32_u32_sdwa v162, v125 dst_sel:DWORD dst_unused:UNUSED_PAD src0_sel:WORD_0
    v_cvt_f32_u32_sdwa v163, v125 dst_sel:DWORD dst_unused:UNUSED_PAD src0_sel:WORD_1
    v_permlane32_swap_b32 v132, v133
    v_max_f32 v143, v132, v133
    v_sub_f32 v134, v252, v143
    v_exp_f32 v134, v134
    v_cvt_f32_u32_sdwa v164, v126 dst_sel:DWORD dst_unused:UNUSED_PAD src0_sel:WORD_0
    v_cvt_f32_u32_sdwa v165, v126 dst_sel:DWORD dst_unused:UNUSED_PAD src0_sel:WORD_1
    v_mul_f32 v142, v134, v254
    v_mov_b32_dpp v135, v134 quad_perm:[0,0,2,2] row_mask:0xf bank_mask:0xf
    v_mov_b32_dpp v136, v134 quad_perm:[1,1,3,3] row_mask:0xf bank_mask:0xf
    v_cvt_f32_u32_sdwa v166, v127 dst_sel:DWORD dst_unused:UNUSED_PAD src0_sel:WORD_0
    v_cvt_f32_u32_sdwa v167, v127 dst_sel:DWORD dst_unused:UNUSED_PAD src0_sel:WORD_1
    v_add_f32_dpp v142, v142, v142 quad_perm:[1,0,3,2] row_mask:0xf bank_mask:0xf
    v_add_f32 v137, v135, v136
    v_mul_f32 v137, 0xc6000000, v137
    v_add_f32_dpp v142, v142, v142 quad_perm:[2,3,0,1] row_mask:0xf bank_mask:0xf
    v_fma_f32 v144, v135, v152, v137
    v_fma_f32 v145, v135, v153, v137
    v_add_f32_dpp v142, v142, v142 row_ror:4 row_mask:0xf bank_mask:0xf
    v_fma_f32 v146, v135, v154, v137
    v_fma_f32 v147, v135, v155, v137
    v_add_f32_dpp v142, v142, v142 row_ror:8 row_mask:0xf bank_mask:0xf
    v_fma_f32 v148, v135, v156, v137
    v_mov_b32 v138, v142
    v_fma_f32 v149, v135, v157, v137
    v_fma_f32 v150, v135, v158, v137
    v_permlane16_swap_b32 v142, v138
    v_add_f32 v142, v142, v138
    v_mov_b32 v138, v142
    v_fma_f32 v151, v135, v159, v137
    v_fmac_f32 v144, v136, v160
    v_fmac_f32 v145, v136, v161
    v_permlane32_swap_b32 v142, v138
    v_add_f32 v142, v142, v138
    v_fmac_f32 v146, v136, v162
    v_fmac_f32 v147, v136, v163
    v_fmac_f32 v148, v136, v164
    v_fmac_f32 v149, v136, v165
    v_fmac_f32 v150, v136, v166
    v_fmac_f32 v151, v136, v167
    v_permlane32_swap_b32 v144, v148
    v_permlane32_swap_b32 v145, v149
    v_permlane32_swap_b32 v146, v150
    v_permlane32_swap_b32 v147, v151
    v_add_f32 v144, v144, v148
    v_add_f32 v146, v146, v150
    v_add_f32 v145, v145, v149
    v_add_f32 v147, v147, v151
    v_permlane16_swap_b32 v144, v146
    v_add_f32 v140, v144, v146
    v_permlane16_swap_b32 v145, v147
    v_add_f32 v141, v145, v147
    v_add_f32_dpp v140, v140, v140 row_ror:8 row_mask:0xf bank_mask:0xf
    s_nop 0
    v_add_f32_dpp v141, v141, v141 row_ror:8 row_mask:0xf bank_mask:0xf
    v_add_f32_dpp v140, v140, v140 row_ror:4 row_mask:0xf bank_mask:0xf
    s_nop 0
    v_add_f32_dpp v141, v141, v141 row_ror:4 row_mask:0xf bank_mask:0xf
    v_add_f32_dpp v140, v140, v140 row_ror:2 row_mask:0xf bank_mask:0xf
    s_nop 0
    v_add_f32_dpp v141, v141, v141 row_ror:2 row_mask:0xf bank_mask:0xf
    s_mov_b64 exec, s[6:7]
    ds_write_b128 v247, v[140:143]
    s_waitcnt lgkmcnt(0)
    s_barrier
    s_cmp_lg_u32 s3, 0
    s_cbranch_scc1 L_fin
    ds_read_b128 v[168:171], v246 offset:20480
    ds_read_b128 v[172:175], v246 offset:20608
    ds_read_b128 v[176:179], v246 offset:20736
    ds_read_b128 v[180:183], v246 offset:20864
    s_waitcnt lgkmcnt(0)
    v_max3_f32 v132, v171, v175, v179
    v_max_f32 v132, v132, v183
    v_sub_f32 v171, v171, v132
    v_sub_f32 v175, v175, v132
    v_sub_f32 v179, v179, v132
    v_sub_f32 v183, v183, v132
    v_exp_f32 v171, v171
    v_exp_f32 v175, v175
    v_exp_f32 v179, v179
    v_exp_f32 v183, v183
    s_nop 0
    v_mul_f32 v142, v171, v170
    v_mul_f32 v140, v171, v168
    v_mul_f32 v141, v171, v169
    v_fmac_f32 v142, v175, v174
    v_fmac_f32 v140, v175, v172
    v_fmac_f32 v141, v175, v173
    v_fmac_f32 v142, v179, v178
    v_fmac_f32 v140, v179, v176
    v_fmac_f32 v141, v179, v177
    v_fmac_f32 v142, v183, v182
    v_fmac_f32 v140, v183, v180
    v_fmac_f32 v141, v183, v181
    v_rcp_f32 v142, v142
    s_nop 0
    v_mul_f32 v140, v140, v142
    v_mul_f32 v141, v141, v142
    v_cvt_pk_bf16_f32 v140, v140, v141
    buffer_store_dword v140, v248, s[76:79], s15 offen
L_fin:
L_end1:
    s_endpgm
.section .rodata,"a"
.p2align 6
.amdhsa_kernel standalone__paged_block_table_kv_radixattention__decode_kernel
  .amdhsa_next_free_vgpr 256
  .amdhsa_next_free_sgpr 102
  .amdhsa_accum_offset 256
  .amdhsa_group_segment_fixed_size 0
  .amdhsa_kernarg_size 64
  .amdhsa_user_sgpr_count 2
  .amdhsa_user_sgpr_kernarg_segment_ptr 1
  .amdhsa_system_sgpr_workgroup_id_x 1
.end_amdhsa_kernel
```
